```python
import torch

def _softmax(x, axis=-1):
    return torch.softmax(x, dim=axis)
def _gelu(x):
    return torch.nn.functional.gelu(x, approximate="tanh")
def _silu(x):
    return torch.nn.functional.silu(x)
def _sigmoid(x):
    return torch.sigmoid(x)
def _layernorm(x, axis=-1, eps=1e-5):
    m = x.mean(dim=axis, keepdim=True)
    v = x.var(dim=axis, keepdim=True, unbiased=False)
    return (x - m) / torch.sqrt(v + eps)
def _scatter_add(tgt, idx, src, axis=0):
    return tgt.clone().index_add_(axis, idx, src)
def _segment_sum(src, seg, n):
    out = torch.zeros((n,) + src.shape[1:], dtype=src.dtype)
    return out.index_add_(0, seg, src)
def _pad(x, pw):
    flat = tuple(v for pair in reversed(pw) for v in pair)
    return torch.nn.functional.pad(x, flat)

kernel_name = 'standalone__se_block__vision'

def setup_inputs():

    _w = (lambda a: (lambda t: t.to(torch.bfloat16) if t.is_floating_point() else t)(torch.as_tensor(a)))
    H = W = 512
    C = 96; r = max(C // 16, 4)
    return {
        "x": _w((lambda *s: torch.randn(*s, dtype=torch.bfloat16) * 3.2)(1, H, W, C)),
        "w_down": _w((lambda *s: torch.randn(*s, dtype=torch.bfloat16) * 12.8)(C, r)),
        "w_up": _w((lambda *s: torch.randn(*s, dtype=torch.bfloat16) * 3.2)(r, C)),
    }

def reference(x, w_down, w_up):
    s = x.mean(axis=(1, 2))
    s = _sigmoid(_silu(s @ w_down) @ w_up)
    return x * s[:, None, None, :]
```

```asm
; @launch grid=(256,1,1) block=(832,1,1) lds=27456
.amdgcn_target "amdgcn-amd-amdhsa--gfx950"
.text
.globl standalone__se_block__vision_kernel
.p2align 8
.type standalone__se_block__vision_kernel,@function
standalone__se_block__vision_kernel:
    s_load_dwordx2 s[20:21], s[0:1], 0
    v_readfirstlane_b32 s3, v0
    s_cmpk_ge_u32 s2, 256
    s_cbranch_scc1 L_end
    s_mul_i32 s16, s2, 73728
    s_mov_b32 s22, 50331648
    s_mov_b32 s23, 0x20000
    s_lshr_b32 s3, s3, 6
    s_cbranch_scc0 L_ctrl
    v_subrev_u32 v0, 64, v0
    s_sub_u32 s3, s3, 1
    v_lshl_add_u32 v2, v0, 4, s16
    s_waitcnt lgkmcnt(0)
    buffer_load_dwordx4 v[16:19], v2, s[20:23], 0 offen nt
    s_mov_b32 s33, 12288
    buffer_load_dwordx4 v[20:23], v2, s[20:23], s33 offen nt
    s_mov_b32 s34, 24576
    buffer_load_dwordx4 v[24:27], v2, s[20:23], s34 offen nt
    s_mov_b32 s35, 36864
    buffer_load_dwordx4 v[28:31], v2, s[20:23], s35 offen nt
    v_mov_b32 v89, 27392
    v_mov_b32 v90, 0
    ds_write_b32 v89, v90
    s_waitcnt lgkmcnt(0)
    s_barrier
    s_branch L_data2
L_ctrl:
    s_load_dwordx4 s[12:15], s[0:1], 32
    s_load_dwordx2 s[26:27], s[0:1], 24
    s_load_dwordx4 s[36:39], s[0:1], 8
    s_getpc_b64 s[56:57]
L_pc:
    v_lshlrev_b32 v20, 7, v0
    s_sub_u32 s56, s56, L_pc-standalone__se_block__vision_kernel
    s_subb_u32 s57, s57, 0
    v_min_u32 v20, L_last-standalone__se_block__vision_kernel, v20
    v_mov_b32 v21, s57
    v_add_co_u32 v20, vcc, s56, v20
    s_nop 1
    v_addc_co_u32 v21, vcc, 0, v21, vcc
    global_load_dword v22, v[20:21], off
    s_setprio 3
    s_sub_u32 s40, s2, 16
    s_mov_b32 s45, 25165824
    s_bitcmp1_b32 s40, 0
    s_cselect_b32 s45, 37748736, s45
    s_lshr_b32 s42, s40, 1
    s_cmp_ge_u32 s40, 12
    s_cselect_b32 s45, 0x80000, s45
    s_cselect_b32 s42, s40, s42
    s_and_b32 s41, s42, 1
    s_lshl_b32 s46, s42, 14
    s_add_u32 s45, s45, s46
    s_lshl_b32 s46, s41, 13
    s_add_u32 s45, s45, s46
    s_xor_b32 s46, s45, 0x2000
    s_movk_i32 s6, 0x100
    s_mov_b32 s7, 0x20000
    s_cmp_ge_u32 s40, 16
    s_waitcnt lgkmcnt(0)
    s_mov_b32 s4, s12
    s_mov_b32 s5, s13
    s_cbranch_scc1 L_noprobe
    s_sub_u32 s43, s26, s20
    s_sub_u32 s43, s43, 0xc00
    s_and_b32 s43, s43, 0x1fff
    s_cmp_le_u32 s43, 0x800
    s_cselect_b32 s42, 1, s41
    s_cmp_eq_u32 s42, 1
    s_cselect_b64 s[54:55], s[26:27], s[20:21]
    s_cmp_ge_u32 s40, 12
    s_cselect_b64 s[54:55], s[14:15], s[54:55]
.p2align 5
    s_load_dword s47, s[54:55], s45 glc
    s_load_dword s48, s[54:55], s46 glc
    s_waitcnt lgkmcnt(1)
    s_getreg_b32 s51, hwreg(HW_REG_IB_STS, 8, 4)
    s_getreg_b32 s51, hwreg(HW_REG_IB_STS, 8, 4)
    s_getreg_b32 s51, hwreg(HW_REG_IB_STS, 8, 4)
    s_getreg_b32 s49, hwreg(HW_REG_XCC_ID, 0, 3)
    s_sub_u32 s50, s49, s2
    s_and_b32 s50, s50, 7
    s_lshl_b32 s50, s50, 28
    s_cmp_eq_u32 s40, 0
    s_cselect_b32 s50, s50, 0
    s_bitset1_b32 s50, 20
    s_lshr_b32 s49, s49, 2
    s_xor_b32 s49, s49, s41
    s_cmp_eq_u32 s51, 0
    s_cselect_b32 s51, 1, 0
    s_xor_b32 s49, s49, s51
    s_and_b32 s51, s40, 1
    s_lshl_b32 s42, s42, 1
    s_add_u32 s42, s42, s51
    s_cmp_ge_u32 s40, 12
    s_cselect_b32 s42, 4, s42
    s_lshl_b32 s42, s42, 2
    s_lshl_b32 s49, s49, s42
    s_or_b32 s50, s50, s49
    s_atomic_add s50, s[12:13], 192
    s_atomic_add s50, s[12:13], 128
    s_atomic_add s50, s[12:13], 64
L_noprobe:
    s_barrier
    v_mov_b32 v13, 27392
    s_sub_u32 s34, s2, 32
    s_lshr_b32 s35, s34, 4
    s_lshr_b32 s16, s35, 3
    s_lshl_b32 s16, s16, 2
    s_and_b32 s17, s35, 3
    s_add_u32 s16, s16, s17
    s_lshl_b32 s16, s16, 1
    s_bfe_u32 s17, s35, 0x10002
    s_add_u32 s16, s16, s17
    s_lshl_b32 s16, s16, 13
    s_lshl_b32 s17, s34, 9
    s_and_b32 s17, s17, 0x1c00
    s_add_u32 s16, s16, s17
    v_lshl_add_u32 v2, v0, 4, s16
    v_mov_b32 v16, -1
    v_mov_b32 v17, -1
    v_mov_b32 v18, -1
    v_mov_b32 v19, -1
    v_bfe_u32 v3, v0, 1, 3
    v_lshrrev_b32 v5, 4, v0
    v_and_b32 v6, 1, v0
    v_lshl_add_u32 v5, v5, 1, v6
    v_mul_u32_u24 v5, 2048, v5
    v_lshl_add_u32 v14, v3, 2, v5
    s_lshl_b32 s17, s35, 7
    s_add_u32 s17, s17, 393216
    v_add_u32 v4, s17, v14
    s_mov_b32 s28, s14
    s_mov_b32 s29, s15
    s_mov_b32 s30, 0x200000
    s_mov_b32 s31, 0x20000
    s_movk_i32 s44, 0x1000
    s_sub_u32 s43, s26, s20
    s_and_b32 s43, s43, 0x1fff
    s_mov_b32 s8, s38
    s_mov_b32 s9, s39
    s_mov_b32 s10, 1152
    s_mov_b32 s11, 0x20000
    s_mov_b32 s24, s36
    s_mov_b32 s25, s37
    s_mov_b32 s26, 1152
    s_mov_b32 s27, 0x20000
    s_mov_b32 s19, 200000
    v_lshlrev_b32 v1, 2, v0
    s_bitcmp1_b32 s34, 0
    s_cselect_b32 s34, -1, s34
    s_cmp_ge_u32 s34, 192
    s_cbranch_scc1 L_noinit
    buffer_store_dwordx4 v[16:19], v2, s[28:31], 0 offen sc1
    s_and_b32 s17, s34, 15
    s_cbranch_scc1 L_noinit
    buffer_store_dword v16, v4, s[28:31], 0 offen sc1
L_noinit:
    s_sub_u32 s40, s2, 16
    s_cmp_lt_u32 s40, 16
    s_cbranch_scc1 L_nosleep
    s_sleep 12
L_nosleep:
    s_sleep 12
    s_waitcnt lgkmcnt(0)
    s_load_dword s76, s[12:13], 192
    s_waitcnt lgkmcnt(0)
    s_and_b32 s92, s76, 0x0f000000
    s_cbranch_scc1 L_info
    s_load_dword s76, s[12:13], 128
    s_waitcnt lgkmcnt(0)
    s_and_b32 s92, s76, 0x0f000000
    s_cbranch_scc1 L_info
    s_load_dword s76, s[12:13], 64
    s_waitcnt lgkmcnt(0)
    s_and_b32 s92, s76, 0x0f000000
    s_cbranch_scc1 L_info
    v_mov_b32 v11, 192
L_ipoll:
    buffer_load_dword v12, v11, s[4:7], 0 offen sc1
    s_sub_u32 s19, s19, 1
    s_cmp_lt_i32 s19, 0
    s_cbranch_scc1 L_info
    s_waitcnt vmcnt(0)
    v_readfirstlane_b32 s76, v12
    s_and_b32 s92, s76, 0x0f000000
    s_cbranch_scc0 L_ipoll
L_info:
    s_bfe_u32 s40, s76, 0x3001c
    s_add_u32 s40, s40, s2
    s_and_b32 s40, s40, 7
    s_lshr_b32 s41, s40, 2
    s_bitcmp1_b32 s2, 3
    s_cselect_b32 s42, -1, 0
    s_add_u32 s45, s76, 0x6666
    s_lshr_b32 s46, s45, 8
    s_xor_b32 s48, s46, s45
    s_cmp_gt_u32 s43, 0x1400
    s_cselect_b32 s46, -1, 0
    s_xor_b32 s48, s48, s46
    s_add_u32 s46, s76, 0x4400
    s_add_u32 s47, s76, 0x5500
    s_xor_b32 s47, s47, s46
    s_lshr_b32 s47, s47, 8
    s_sub_u32 s49, s43, 0xc00
    s_cmp_le_u32 s49, 0x800
    s_cselect_b32 s48, s47, s48
    s_cselect_b32 s49, s46, s45
    s_mov_b32 s47, 0xaaaaaaaa
    s_bitcmp1_b32 s49, 11
    s_cselect_b32 s45, 0x55555555, s47
    s_bitcmp1_b32 s48, 3
    s_cselect_b32 s45, s42, s45
    s_and_b32 s45, s45, 0xffff
    s_bitcmp1_b32 s49, 15
    s_cselect_b32 s46, 0x55555555, s47
    s_bitcmp1_b32 s48, 7
    s_cselect_b32 s46, s42, s46
    s_and_b32 s46, s46, 0x3ff0000
    s_or_b32 s45, s45, s46
    s_mul_i32 s46, s41, 0x3ffffff
    s_xor_b32 s45, s45, s46
    s_bitset1_b32 s45, 31
    v_mov_b32 v12, s45
    ds_write_b32 v13, v12
    s_branch L_ctrl2
L_data2:
    s_load_dwordx2 s[24:25], s[0:1], 24
    s_load_dwordx4 s[12:15], s[0:1], 32
    s_mov_b32 s36, 49152
    s_mov_b32 s37, 61440
    s_mul_i32 s48, s3, 43
    s_lshr_b32 s48, s48, 7
    s_mul_i32 s49, s48, 3
    s_sub_u32 s49, s3, s49
    s_lshl_b32 s48, s48, 2
    s_waitcnt lgkmcnt(0)
    s_bfe_u32 s18, s24, 0x3000a
    s_add_u32 s49, s49, s18
    s_mul_i32 s50, s49, 43
    s_lshr_b32 s50, s50, 7
    s_mul_i32 s50, s50, 3
    s_sub_u32 s49, s49, s50
    s_cmp_eq_u32 s49, 1
    s_mov_b32 s50, 3703005712
    s_mov_b32 s51, 3413529104
    s_cselect_b32 s50, s51, s50
    s_cselect_b32 s51, 3416745232, s51
    s_cmp_eq_u32 s49, 2
    s_cselect_b32 s50, 3416745232, s50
    s_cselect_b32 s51, 3703005712, s51
    s_cselect_b32 s58, 8, 9
    s_cselect_b32 s59, 0, s49
    s_add_u32 s58, s58, s59
    s_lshr_b32 s50, s50, s48
    s_lshr_b32 s51, s51, s48
    s_and_b32 s52, s50, 15
    s_bfe_u32 s53, s50, 262160
    s_and_b32 s54, s51, 15
    s_bfe_u32 s55, s51, 262160
    s_mul_i32 s52, s52, 3
    s_mul_i32 s53, s53, 3
    s_mul_i32 s54, s54, 3
    s_mul_i32 s55, s55, 3
    s_add_u32 s52, s52, s49
    s_add_u32 s53, s53, s49
    s_add_u32 s54, s54, s58
    s_add_u32 s55, s55, s58
    s_sub_u32 s52, s52, s18
    s_cselect_b32 s50, 48, 0
    s_add_u32 s52, s52, s50
    s_sub_u32 s53, s53, s18
    s_sub_u32 s54, s54, s18
    s_sub_u32 s55, s55, s18
    s_lshr_b32 s48, s2, 3
    s_lshl_b32 s48, s48, 2
    s_and_b32 s49, s2, 3
    s_add_u32 s48, s48, s49
    s_mul_i32 s48, s48, 49152
    s_lshl_b32 s49, s3, 10
    s_add_u32 s49, s49, s16
    s_lshl_b32 s52, s52, 10
    s_lshl_b32 s53, s53, 10
    s_lshl_b32 s54, s54, 10
    s_lshl_b32 s55, s55, 10
    s_sub_u32 s52, s52, s49
    s_sub_u32 s53, s53, s49
    s_sub_u32 s54, s54, s49
    s_sub_u32 s55, s55, s49
    s_and_b32 s49, s24, 0x1fffff
    s_mov_b32 s26, 50331648
    s_mov_b32 s27, 0x20000
    s_mov_b32 s30, 0x200000
    s_mov_b32 s31, 0x20000
    s_mov_b32 s10, 48
    s_mov_b32 s11, 0x20000
    s_mov_b32 s19, 200000
    s_mov_b32 s56, 0xcccccccc
    s_mov_b32 s57, 0xcccccccc
    v_mul_u32_u24 v3, 43691, v0
    v_lshrrev_b32 v3, 19, v3
    v_mul_u32_u24 v4, 12, v3
    v_sub_u32 v4, v0, v4
    v_add_lshl_u32 v5, v0, v3, 4
    v_lshlrev_b32 v6, 5, v4
    v_add_u32 v6, 26880, v6
    v_and_b32 v1, 63, v0
    v_and_b32 v4, 1, v1
    v_lshrrev_b32 v3, 1, v1
    v_mul_u32_u24 v3, 208, v3
    v_mul_u32_u24 v7, 13440, v4
    s_lshl_b32 s17, s3, 4
    v_add3_u32 v3, v3, v7, s17
    v_lshlrev_b32 v7, 4, v4
    v_and_b32 v80, 2, v1
    v_lshl_add_u32 v7, v80, 2, v7
    v_and_b32 v80, 4, v1
    v_add_u32 v7, v7, v80
    s_lshr_b32 s17, s3, 3
    s_lshl_b32 s17, s17, 2
    s_and_b32 s8, s3, 3
    s_add_u32 s17, s17, s8
    s_lshl_b32 s17, s17, 1
    s_bfe_u32 s8, s3, 0x10002
    s_add_u32 s17, s17, s8
    s_lshl_b32 s17, s17, 13
    s_lshl_b32 s8, s2, 5
    s_add_u32 s17, s17, s8
    v_add_u32 v7, s17, v7
    v_mov_b32 v4, 0
    s_waitcnt lgkmcnt(0)
    s_mov_b32 s8, s12
    s_mov_b32 s9, s13
    s_mov_b32 s28, s14
    s_mov_b32 s29, s15
    s_waitcnt vmcnt(3)
    buffer_load_dwordx4 v[32:35], v2, s[20:23], s36 offen nt
    v_lshlrev_b32 v8, 16, v16
    v_and_b32 v9, 0xffff0000, v16
    v_lshlrev_b32 v10, 16, v17
    v_and_b32 v11, 0xffff0000, v17
    v_lshlrev_b32 v12, 16, v18
    v_and_b32 v13, 0xffff0000, v18
    v_lshlrev_b32 v14, 16, v19
    v_and_b32 v15, 0xffff0000, v19
    s_waitcnt vmcnt(3)
    buffer_load_dwordx4 v[36:39], v2, s[20:23], s37 offen nt
    v_lshlrev_b32 v80, 16, v20
    v_and_b32 v81, 0xffff0000, v20
    v_lshlrev_b32 v82, 16, v21
    v_and_b32 v83, 0xffff0000, v21
    v_lshlrev_b32 v84, 16, v22
    v_and_b32 v85, 0xffff0000, v22
    v_lshlrev_b32 v86, 16, v23
    v_and_b32 v87, 0xffff0000, v23
    v_pk_add_f32 v[8:9], v[8:9], v[80:81]
    v_pk_add_f32 v[10:11], v[10:11], v[82:83]
    v_pk_add_f32 v[12:13], v[12:13], v[84:85]
    v_pk_add_f32 v[14:15], v[14:15], v[86:87]
L_iw:
    ds_read_b32 v90, v89
    s_sub_u32 s19, s19, 1
    s_cmp_lt_i32 s19, 0
    s_cbranch_scc1 L_iok
    s_waitcnt lgkmcnt(0)
    v_readfirstlane_b32 s58, v90
    s_bitcmp1_b32 s58, 31
    s_cbranch_scc0 L_iw
L_iok:
    s_mul_i32 s59, s48, 2
    s_add_u32 s59, s59, 18874368
    s_add_u32 s50, s59, s49
    s_lshr_b32 s50, s50, 21
    s_bitcmp1_b32 s58, s50
    s_cselect_b32 s38, s54, s52
    s_cselect_b32 s39, s55, s53
    s_add_u32 s38, s38, s59
    s_add_u32 s39, s39, s59
    s_add_u32 s59, s59, 49152
    s_add_u32 s50, s59, s49
    s_lshr_b32 s50, s50, 21
    s_bitcmp1_b32 s58, s50
    s_cselect_b32 s40, s54, s52
    s_cselect_b32 s41, s55, s53
    s_add_u32 s40, s40, s59
    s_add_u32 s41, s41, s59
    s_mul_i32 s59, s48, 2
    s_add_u32 s59, s59, 31457280
    s_add_u32 s50, s59, s49
    s_lshr_b32 s50, s50, 21
    s_bitcmp1_b32 s58, s50
    s_cselect_b32 s42, s54, s52
    s_cselect_b32 s43, s55, s53
    s_add_u32 s42, s42, s59
    s_add_u32 s43, s43, s59
    s_add_u32 s59, s59, 49152
    s_add_u32 s50, s59, s49
    s_lshr_b32 s50, s50, 21
    s_bitcmp1_b32 s58, s50
    s_cselect_b32 s44, s54, s52
    s_cselect_b32 s45, s55, s53
    s_add_u32 s44, s44, s59
    s_add_u32 s45, s45, s59
    s_mul_i32 s59, s48, 1
    s_add_u32 s59, s59, 44040192
    s_add_u32 s50, s59, s49
    s_lshr_b32 s50, s50, 21
    s_bitcmp1_b32 s58, s50
    s_cselect_b32 s46, s54, s52
    s_cselect_b32 s47, s55, s53
    s_add_u32 s46, s46, s59
    s_add_u32 s47, s47, s59
    s_waitcnt vmcnt(3)
    buffer_load_dwordx4 v[40:43], v2, s[20:23], s38 offen nt
    v_lshlrev_b32 v80, 16, v24
    v_and_b32 v81, 0xffff0000, v24
    v_lshlrev_b32 v82, 16, v25
    v_and_b32 v83, 0xffff0000, v25
    v_lshlrev_b32 v84, 16, v26
    v_and_b32 v85, 0xffff0000, v26
    v_lshlrev_b32 v86, 16, v27
    v_and_b32 v87, 0xffff0000, v27
    v_pk_add_f32 v[8:9], v[8:9], v[80:81]
    v_pk_add_f32 v[10:11], v[10:11], v[82:83]
    v_pk_add_f32 v[12:13], v[12:13], v[84:85]
    v_pk_add_f32 v[14:15], v[14:15], v[86:87]
    s_waitcnt vmcnt(3)
    buffer_load_dwordx4 v[44:47], v2, s[20:23], s39 offen nt
    v_lshlrev_b32 v80, 16, v28
    v_and_b32 v81, 0xffff0000, v28
    v_lshlrev_b32 v82, 16, v29
    v_and_b32 v83, 0xffff0000, v29
    v_lshlrev_b32 v84, 16, v30
    v_and_b32 v85, 0xffff0000, v30
    v_lshlrev_b32 v86, 16, v31
    v_and_b32 v87, 0xffff0000, v31
    v_pk_add_f32 v[8:9], v[8:9], v[80:81]
    v_pk_add_f32 v[10:11], v[10:11], v[82:83]
    v_pk_add_f32 v[12:13], v[12:13], v[84:85]
    v_pk_add_f32 v[14:15], v[14:15], v[86:87]
    s_waitcnt vmcnt(3)
    buffer_load_dwordx4 v[48:51], v2, s[20:23], s40 offen nt
    v_lshlrev_b32 v80, 16, v32
    v_and_b32 v81, 0xffff0000, v32
    v_lshlrev_b32 v82, 16, v33
    v_and_b32 v83, 0xffff0000, v33
    v_lshlrev_b32 v84, 16, v34
    v_and_b32 v85, 0xffff0000, v34
    v_lshlrev_b32 v86, 16, v35
    v_and_b32 v87, 0xffff0000, v35
    v_pk_add_f32 v[8:9], v[8:9], v[80:81]
    v_pk_add_f32 v[10:11], v[10:11], v[82:83]
    v_pk_add_f32 v[12:13], v[12:13], v[84:85]
    v_pk_add_f32 v[14:15], v[14:15], v[86:87]
    s_waitcnt vmcnt(3)
    buffer_load_dwordx4 v[52:55], v2, s[20:23], s41 offen nt
    v_lshlrev_b32 v80, 16, v36
    v_and_b32 v81, 0xffff0000, v36
    v_lshlrev_b32 v82, 16, v37
    v_and_b32 v83, 0xffff0000, v37
    v_lshlrev_b32 v84, 16, v38
    v_and_b32 v85, 0xffff0000, v38
    v_lshlrev_b32 v86, 16, v39
    v_and_b32 v87, 0xffff0000, v39
    v_pk_add_f32 v[8:9], v[8:9], v[80:81]
    v_pk_add_f32 v[10:11], v[10:11], v[82:83]
    v_pk_add_f32 v[12:13], v[12:13], v[84:85]
    v_pk_add_f32 v[14:15], v[14:15], v[86:87]
    s_waitcnt vmcnt(3)
    buffer_load_dwordx4 v[56:59], v2, s[20:23], s42 offen nt
    v_lshlrev_b32 v80, 16, v40
    v_and_b32 v81, 0xffff0000, v40
    v_lshlrev_b32 v82, 16, v41
    v_and_b32 v83, 0xffff0000, v41
    v_lshlrev_b32 v84, 16, v42
    v_and_b32 v85, 0xffff0000, v42
    v_lshlrev_b32 v86, 16, v43
    v_and_b32 v87, 0xffff0000, v43
    v_pk_add_f32 v[8:9], v[8:9], v[80:81]
    v_pk_add_f32 v[10:11], v[10:11], v[82:83]
    v_pk_add_f32 v[12:13], v[12:13], v[84:85]
    v_pk_add_f32 v[14:15], v[14:15], v[86:87]
    s_waitcnt vmcnt(3)
    buffer_load_dwordx4 v[60:63], v2, s[20:23], s43 offen nt
    v_lshlrev_b32 v80, 16, v44
    v_and_b32 v81, 0xffff0000, v44
    v_lshlrev_b32 v82, 16, v45
    v_and_b32 v83, 0xffff0000, v45
    v_lshlrev_b32 v84, 16, v46
    v_and_b32 v85, 0xffff0000, v46
    v_lshlrev_b32 v86, 16, v47
    v_and_b32 v87, 0xffff0000, v47
    v_pk_add_f32 v[8:9], v[8:9], v[80:81]
    v_pk_add_f32 v[10:11], v[10:11], v[82:83]
    v_pk_add_f32 v[12:13], v[12:13], v[84:85]
    v_pk_add_f32 v[14:15], v[14:15], v[86:87]
    s_waitcnt vmcnt(3)
    buffer_load_dwordx4 v[64:67], v2, s[20:23], s44 offen nt
    v_lshlrev_b32 v80, 16, v48
    v_and_b32 v81, 0xffff0000, v48
    v_lshlrev_b32 v82, 16, v49
    v_and_b32 v83, 0xffff0000, v49
    v_lshlrev_b32 v84, 16, v50
    v_and_b32 v85, 0xffff0000, v50
    v_lshlrev_b32 v86, 16, v51
    v_and_b32 v87, 0xffff0000, v51
    v_pk_add_f32 v[8:9], v[8:9], v[80:81]
    v_pk_add_f32 v[10:11], v[10:11], v[82:83]
    v_pk_add_f32 v[12:13], v[12:13], v[84:85]
    v_pk_add_f32 v[14:15], v[14:15], v[86:87]
    s_waitcnt vmcnt(3)
    buffer_load_dwordx4 v[68:71], v2, s[20:23], s45 offen nt
    v_lshlrev_b32 v80, 16, v52
    v_and_b32 v81, 0xffff0000, v52
    v_lshlrev_b32 v82, 16, v53
    v_and_b32 v83, 0xffff0000, v53
    v_lshlrev_b32 v84, 16, v54
    v_and_b32 v85, 0xffff0000, v54
    v_lshlrev_b32 v86, 16, v55
    v_and_b32 v87, 0xffff0000, v55
    v_pk_add_f32 v[8:9], v[8:9], v[80:81]
    v_pk_add_f32 v[10:11], v[10:11], v[82:83]
    v_pk_add_f32 v[12:13], v[12:13], v[84:85]
    v_pk_add_f32 v[14:15], v[14:15], v[86:87]
    s_waitcnt vmcnt(3)
    buffer_load_dwordx4 v[72:75], v2, s[20:23], s46 offen nt
    v_lshlrev_b32 v80, 16, v56
    v_and_b32 v81, 0xffff0000, v56
    v_lshlrev_b32 v82, 16, v57
    v_and_b32 v83, 0xffff0000, v57
    v_lshlrev_b32 v84, 16, v58
    v_and_b32 v85, 0xffff0000, v58
    v_lshlrev_b32 v86, 16, v59
    v_and_b32 v87, 0xffff0000, v59
    v_pk_add_f32 v[8:9], v[8:9], v[80:81]
    v_pk_add_f32 v[10:11], v[10:11], v[82:83]
    v_pk_add_f32 v[12:13], v[12:13], v[84:85]
    v_pk_add_f32 v[14:15], v[14:15], v[86:87]
    s_waitcnt vmcnt(3)
    buffer_load_dword v88, v4, s[8:11], 0 offen sc1
    buffer_load_dwordx4 v[76:79], v2, s[20:23], s47 offen nt
    v_lshlrev_b32 v80, 16, v60
    v_and_b32 v81, 0xffff0000, v60
    v_lshlrev_b32 v82, 16, v61
    v_and_b32 v83, 0xffff0000, v61
    v_lshlrev_b32 v84, 16, v62
    v_and_b32 v85, 0xffff0000, v62
    v_lshlrev_b32 v86, 16, v63
    v_and_b32 v87, 0xffff0000, v63
    v_pk_add_f32 v[8:9], v[8:9], v[80:81]
    v_pk_add_f32 v[10:11], v[10:11], v[82:83]
    v_pk_add_f32 v[12:13], v[12:13], v[84:85]
    v_pk_add_f32 v[14:15], v[14:15], v[86:87]
    s_waitcnt vmcnt(4)
    v_lshlrev_b32 v80, 16, v64
    v_and_b32 v81, 0xffff0000, v64
    v_lshlrev_b32 v82, 16, v65
    v_and_b32 v83, 0xffff0000, v65
    v_lshlrev_b32 v84, 16, v66
    v_and_b32 v85, 0xffff0000, v66
    v_lshlrev_b32 v86, 16, v67
    v_and_b32 v87, 0xffff0000, v67
    v_pk_add_f32 v[8:9], v[8:9], v[80:81]
    v_pk_add_f32 v[10:11], v[10:11], v[82:83]
    v_pk_add_f32 v[12:13], v[12:13], v[84:85]
    v_pk_add_f32 v[14:15], v[14:15], v[86:87]
    s_waitcnt vmcnt(3)
    v_lshlrev_b32 v80, 16, v68
    v_and_b32 v81, 0xffff0000, v68
    v_lshlrev_b32 v82, 16, v69
    v_and_b32 v83, 0xffff0000, v69
    v_lshlrev_b32 v84, 16, v70
    v_and_b32 v85, 0xffff0000, v70
    v_lshlrev_b32 v86, 16, v71
    v_and_b32 v87, 0xffff0000, v71
    v_pk_add_f32 v[8:9], v[8:9], v[80:81]
    v_pk_add_f32 v[10:11], v[10:11], v[82:83]
    v_pk_add_f32 v[12:13], v[12:13], v[84:85]
    v_pk_add_f32 v[14:15], v[14:15], v[86:87]
    s_waitcnt vmcnt(2)
    v_lshlrev_b32 v80, 16, v72
    v_and_b32 v81, 0xffff0000, v72
    v_lshlrev_b32 v82, 16, v73
    v_and_b32 v83, 0xffff0000, v73
    v_lshlrev_b32 v84, 16, v74
    v_and_b32 v85, 0xffff0000, v74
    v_lshlrev_b32 v86, 16, v75
    v_and_b32 v87, 0xffff0000, v75
    v_pk_add_f32 v[8:9], v[8:9], v[80:81]
    v_pk_add_f32 v[10:11], v[10:11], v[82:83]
    v_pk_add_f32 v[12:13], v[12:13], v[84:85]
    v_pk_add_f32 v[14:15], v[14:15], v[86:87]
    s_waitcnt vmcnt(0)
    v_lshlrev_b32 v80, 16, v76
    v_and_b32 v81, 0xffff0000, v76
    v_lshlrev_b32 v82, 16, v77
    v_and_b32 v83, 0xffff0000, v77
    v_lshlrev_b32 v84, 16, v78
    v_and_b32 v85, 0xffff0000, v78
    v_lshlrev_b32 v86, 16, v79
    v_and_b32 v87, 0xffff0000, v79
    v_pk_add_f32 v[8:9], v[8:9], v[80:81]
    v_pk_add_f32 v[10:11], v[10:11], v[82:83]
    v_pk_add_f32 v[12:13], v[12:13], v[84:85]
    v_pk_add_f32 v[14:15], v[14:15], v[86:87]
    ds_write_b128 v5, v[8:11]
    ds_write_b128 v5, v[12:15] offset:13440
    v_cmp_gt_u32 vcc, 96, v88
    s_cbranch_vccnz L_flagwait
L_flagok:
    s_waitcnt lgkmcnt(0)
    s_barrier
    ds_read_b128 v[8:11], v3
    ds_read_b128 v[12:15], v3 offset:6656
    s_waitcnt lgkmcnt(0)
    v_pk_add_f32 v[8:9], v[8:9], v[12:13]
    v_pk_add_f32 v[10:11], v[10:11], v[14:15]
    s_nop 0
    v_add_f32_dpp v8, v8, v8 quad_perm:[2,3,0,1] row_mask:0xf bank_mask:0xf
    v_add_f32_dpp v9, v9, v9 quad_perm:[2,3,0,1] row_mask:0xf bank_mask:0xf
    v_add_f32_dpp v10, v10, v10 quad_perm:[2,3,0,1] row_mask:0xf bank_mask:0xf
    v_add_f32_dpp v11, v11, v11 quad_perm:[2,3,0,1] row_mask:0xf bank_mask:0xf
    v_cndmask_b32 v8, v8, v10, s[56:57]
    v_cndmask_b32 v9, v9, v11, s[56:57]
    s_nop 0
    v_add_f32_dpp v10, v8, v8 row_shl:4 row_mask:0xf bank_mask:0x5
    v_add_f32_dpp v10, v9, v9 row_shr:4 row_mask:0xf bank_mask:0xa
    s_nop 1
    v_add_f32_dpp v10, v10, v10 row_ror:8 row_mask:0xf bank_mask:0xf
    s_nop 1
    v_permlane16_swap_b32 v10, v11
    v_add_f32 v10, v10, v11
    s_nop 1
    v_permlane32_swap_b32 v10, v11
    v_add_f32 v10, v10, v11
    s_mov_b64 exec, 0xff
    buffer_store_dword v10, v7, s[28:31], 0 offen sc1
    s_mov_b64 exec, -1
    v_lshlrev_b32 v80, 16, v40
    v_and_b32 v81, 0xffff0000, v40
    v_lshlrev_b32 v82, 16, v41
    v_and_b32 v83, 0xffff0000, v41
    v_lshlrev_b32 v84, 16, v42
    v_and_b32 v85, 0xffff0000, v42
    v_lshlrev_b32 v86, 16, v43
    v_and_b32 v87, 0xffff0000, v43
    s_barrier
    ds_read_b128 v[8:11], v6
    ds_read_b128 v[12:15], v6 offset:16
    s_waitcnt lgkmcnt(0)
    v_pk_mul_f32 v[80:81], v[80:81], v[8:9]
    v_pk_mul_f32 v[82:83], v[82:83], v[10:11]
    v_pk_mul_f32 v[84:85], v[84:85], v[12:13]
    v_pk_mul_f32 v[86:87], v[86:87], v[14:15]
    v_cvt_pk_bf16_f32 v40, v80, v81
    v_cvt_pk_bf16_f32 v41, v82, v83
    v_cvt_pk_bf16_f32 v42, v84, v85
    v_cvt_pk_bf16_f32 v43, v86, v87
    buffer_store_dwordx4 v[40:43], v2, s[24:27], s38 offen nt
    v_lshlrev_b32 v80, 16, v16
    v_and_b32 v81, 0xffff0000, v16
    v_lshlrev_b32 v82, 16, v17
    v_and_b32 v83, 0xffff0000, v17
    v_lshlrev_b32 v84, 16, v18
    v_and_b32 v85, 0xffff0000, v18
    v_lshlrev_b32 v86, 16, v19
    v_and_b32 v87, 0xffff0000, v19
    v_pk_mul_f32 v[80:81], v[80:81], v[8:9]
    v_pk_mul_f32 v[82:83], v[82:83], v[10:11]
    v_pk_mul_f32 v[84:85], v[84:85], v[12:13]
    v_pk_mul_f32 v[86:87], v[86:87], v[14:15]
    v_cvt_pk_bf16_f32 v16, v80, v81
    v_cvt_pk_bf16_f32 v17, v82, v83
    v_cvt_pk_bf16_f32 v18, v84, v85
    v_cvt_pk_bf16_f32 v19, v86, v87
    buffer_store_dwordx4 v[16:19], v2, s[24:27], 0 offen sc1
    v_lshlrev_b32 v80, 16, v44
    v_and_b32 v81, 0xffff0000, v44
    v_lshlrev_b32 v82, 16, v45
    v_and_b32 v83, 0xffff0000, v45
    v_lshlrev_b32 v84, 16, v46
    v_and_b32 v85, 0xffff0000, v46
    v_lshlrev_b32 v86, 16, v47
    v_and_b32 v87, 0xffff0000, v47
    v_pk_mul_f32 v[80:81], v[80:81], v[8:9]
    v_pk_mul_f32 v[82:83], v[82:83], v[10:11]
    v_pk_mul_f32 v[84:85], v[84:85], v[12:13]
    v_pk_mul_f32 v[86:87], v[86:87], v[14:15]
    v_cvt_pk_bf16_f32 v44, v80, v81
    v_cvt_pk_bf16_f32 v45, v82, v83
    v_cvt_pk_bf16_f32 v46, v84, v85
    v_cvt_pk_bf16_f32 v47, v86, v87
    buffer_store_dwordx4 v[44:47], v2, s[24:27], s39 offen nt
    v_lshlrev_b32 v80, 16, v20
    v_and_b32 v81, 0xffff0000, v20
    v_lshlrev_b32 v82, 16, v21
    v_and_b32 v83, 0xffff0000, v21
    v_lshlrev_b32 v84, 16, v22
    v_and_b32 v85, 0xffff0000, v22
    v_lshlrev_b32 v86, 16, v23
    v_and_b32 v87, 0xffff0000, v23
    v_pk_mul_f32 v[80:81], v[80:81], v[8:9]
    v_pk_mul_f32 v[82:83], v[82:83], v[10:11]
    v_pk_mul_f32 v[84:85], v[84:85], v[12:13]
    v_pk_mul_f32 v[86:87], v[86:87], v[14:15]
    v_cvt_pk_bf16_f32 v20, v80, v81
    v_cvt_pk_bf16_f32 v21, v82, v83
    v_cvt_pk_bf16_f32 v22, v84, v85
    v_cvt_pk_bf16_f32 v23, v86, v87
    buffer_store_dwordx4 v[20:23], v2, s[24:27], s33 offen sc1
    v_lshlrev_b32 v80, 16, v48
    v_and_b32 v81, 0xffff0000, v48
    v_lshlrev_b32 v82, 16, v49
    v_and_b32 v83, 0xffff0000, v49
    v_lshlrev_b32 v84, 16, v50
    v_and_b32 v85, 0xffff0000, v50
    v_lshlrev_b32 v86, 16, v51
    v_and_b32 v87, 0xffff0000, v51
    v_pk_mul_f32 v[80:81], v[80:81], v[8:9]
    v_pk_mul_f32 v[82:83], v[82:83], v[10:11]
    v_pk_mul_f32 v[84:85], v[84:85], v[12:13]
    v_pk_mul_f32 v[86:87], v[86:87], v[14:15]
    v_cvt_pk_bf16_f32 v48, v80, v81
    v_cvt_pk_bf16_f32 v49, v82, v83
    v_cvt_pk_bf16_f32 v50, v84, v85
    v_cvt_pk_bf16_f32 v51, v86, v87
    buffer_store_dwordx4 v[48:51], v2, s[24:27], s40 offen nt
    v_lshlrev_b32 v80, 16, v52
    v_and_b32 v81, 0xffff0000, v52
    v_lshlrev_b32 v82, 16, v53
    v_and_b32 v83, 0xffff0000, v53
    v_lshlrev_b32 v84, 16, v54
    v_and_b32 v85, 0xffff0000, v54
    v_lshlrev_b32 v86, 16, v55
    v_and_b32 v87, 0xffff0000, v55
    v_pk_mul_f32 v[80:81], v[80:81], v[8:9]
    v_pk_mul_f32 v[82:83], v[82:83], v[10:11]
    v_pk_mul_f32 v[84:85], v[84:85], v[12:13]
    v_pk_mul_f32 v[86:87], v[86:87], v[14:15]
    v_cvt_pk_bf16_f32 v52, v80, v81
    v_cvt_pk_bf16_f32 v53, v82, v83
    v_cvt_pk_bf16_f32 v54, v84, v85
    v_cvt_pk_bf16_f32 v55, v86, v87
    buffer_store_dwordx4 v[52:55], v2, s[24:27], s41 offen nt
    v_lshlrev_b32 v80, 16, v24
    v_and_b32 v81, 0xffff0000, v24
    v_lshlrev_b32 v82, 16, v25
    v_and_b32 v83, 0xffff0000, v25
    v_lshlrev_b32 v84, 16, v26
    v_and_b32 v85, 0xffff0000, v26
    v_lshlrev_b32 v86, 16, v27
    v_and_b32 v87, 0xffff0000, v27
    v_pk_mul_f32 v[80:81], v[80:81], v[8:9]
    v_pk_mul_f32 v[82:83], v[82:83], v[10:11]
    v_pk_mul_f32 v[84:85], v[84:85], v[12:13]
    v_pk_mul_f32 v[86:87], v[86:87], v[14:15]
    v_cvt_pk_bf16_f32 v24, v80, v81
    v_cvt_pk_bf16_f32 v25, v82, v83
    v_cvt_pk_bf16_f32 v26, v84, v85
    v_cvt_pk_bf16_f32 v27, v86, v87
    buffer_store_dwordx4 v[24:27], v2, s[24:27], s34 offen sc1
    v_lshlrev_b32 v80, 16, v56
    v_and_b32 v81, 0xffff0000, v56
    v_lshlrev_b32 v82, 16, v57
    v_and_b32 v83, 0xffff0000, v57
    v_lshlrev_b32 v84, 16, v58
    v_and_b32 v85, 0xffff0000, v58
    v_lshlrev_b32 v86, 16, v59
    v_and_b32 v87, 0xffff0000, v59
    v_pk_mul_f32 v[80:81], v[80:81], v[8:9]
    v_pk_mul_f32 v[82:83], v[82:83], v[10:11]
    v_pk_mul_f32 v[84:85], v[84:85], v[12:13]
    v_pk_mul_f32 v[86:87], v[86:87], v[14:15]
    v_cvt_pk_bf16_f32 v56, v80, v81
    v_cvt_pk_bf16_f32 v57, v82, v83
    v_cvt_pk_bf16_f32 v58, v84, v85
    v_cvt_pk_bf16_f32 v59, v86, v87
    buffer_store_dwordx4 v[56:59], v2, s[24:27], s42 offen nt
    v_lshlrev_b32 v80, 16, v60
    v_and_b32 v81, 0xffff0000, v60
    v_lshlrev_b32 v82, 16, v61
    v_and_b32 v83, 0xffff0000, v61
    v_lshlrev_b32 v84, 16, v62
    v_and_b32 v85, 0xffff0000, v62
    v_lshlrev_b32 v86, 16, v63
    v_and_b32 v87, 0xffff0000, v63
    v_pk_mul_f32 v[80:81], v[80:81], v[8:9]
    v_pk_mul_f32 v[82:83], v[82:83], v[10:11]
    v_pk_mul_f32 v[84:85], v[84:85], v[12:13]
    v_pk_mul_f32 v[86:87], v[86:87], v[14:15]
    v_cvt_pk_bf16_f32 v60, v80, v81
    v_cvt_pk_bf16_f32 v61, v82, v83
    v_cvt_pk_bf16_f32 v62, v84, v85
    v_cvt_pk_bf16_f32 v63, v86, v87
    buffer_store_dwordx4 v[60:63], v2, s[24:27], s43 offen nt
    v_lshlrev_b32 v80, 16, v28
    v_and_b32 v81, 0xffff0000, v28
    v_lshlrev_b32 v82, 16, v29
    v_and_b32 v83, 0xffff0000, v29
    v_lshlrev_b32 v84, 16, v30
    v_and_b32 v85, 0xffff0000, v30
    v_lshlrev_b32 v86, 16, v31
    v_and_b32 v87, 0xffff0000, v31
    v_pk_mul_f32 v[80:81], v[80:81], v[8:9]
    v_pk_mul_f32 v[82:83], v[82:83], v[10:11]
    v_pk_mul_f32 v[84:85], v[84:85], v[12:13]
    v_pk_mul_f32 v[86:87], v[86:87], v[14:15]
    v_cvt_pk_bf16_f32 v28, v80, v81
    v_cvt_pk_bf16_f32 v29, v82, v83
    v_cvt_pk_bf16_f32 v30, v84, v85
    v_cvt_pk_bf16_f32 v31, v86, v87
    buffer_store_dwordx4 v[28:31], v2, s[24:27], s35 offen sc1
    v_lshlrev_b32 v80, 16, v64
    v_and_b32 v81, 0xffff0000, v64
    v_lshlrev_b32 v82, 16, v65
    v_and_b32 v83, 0xffff0000, v65
    v_lshlrev_b32 v84, 16, v66
    v_and_b32 v85, 0xffff0000, v66
    v_lshlrev_b32 v86, 16, v67
    v_and_b32 v87, 0xffff0000, v67
    v_pk_mul_f32 v[80:81], v[80:81], v[8:9]
    v_pk_mul_f32 v[82:83], v[82:83], v[10:11]
    v_pk_mul_f32 v[84:85], v[84:85], v[12:13]
    v_pk_mul_f32 v[86:87], v[86:87], v[14:15]
    v_cvt_pk_bf16_f32 v64, v80, v81
    v_cvt_pk_bf16_f32 v65, v82, v83
    v_cvt_pk_bf16_f32 v66, v84, v85
    v_cvt_pk_bf16_f32 v67, v86, v87
    buffer_store_dwordx4 v[64:67], v2, s[24:27], s44 offen nt
    v_lshlrev_b32 v80, 16, v32
    v_and_b32 v81, 0xffff0000, v32
    v_lshlrev_b32 v82, 16, v33
    v_and_b32 v83, 0xffff0000, v33
    v_lshlrev_b32 v84, 16, v34
    v_and_b32 v85, 0xffff0000, v34
    v_lshlrev_b32 v86, 16, v35
    v_and_b32 v87, 0xffff0000, v35
    v_pk_mul_f32 v[80:81], v[80:81], v[8:9]
    v_pk_mul_f32 v[82:83], v[82:83], v[10:11]
    v_pk_mul_f32 v[84:85], v[84:85], v[12:13]
    v_pk_mul_f32 v[86:87], v[86:87], v[14:15]
    v_cvt_pk_bf16_f32 v32, v80, v81
    v_cvt_pk_bf16_f32 v33, v82, v83
    v_cvt_pk_bf16_f32 v34, v84, v85
    v_cvt_pk_bf16_f32 v35, v86, v87
    buffer_store_dwordx4 v[32:35], v2, s[24:27], s36 offen sc1
    v_lshlrev_b32 v80, 16, v68
    v_and_b32 v81, 0xffff0000, v68
    v_lshlrev_b32 v82, 16, v69
    v_and_b32 v83, 0xffff0000, v69
    v_lshlrev_b32 v84, 16, v70
    v_and_b32 v85, 0xffff0000, v70
    v_lshlrev_b32 v86, 16, v71
    v_and_b32 v87, 0xffff0000, v71
    v_pk_mul_f32 v[80:81], v[80:81], v[8:9]
    v_pk_mul_f32 v[82:83], v[82:83], v[10:11]
    v_pk_mul_f32 v[84:85], v[84:85], v[12:13]
    v_pk_mul_f32 v[86:87], v[86:87], v[14:15]
    v_cvt_pk_bf16_f32 v68, v80, v81
    v_cvt_pk_bf16_f32 v69, v82, v83
    v_cvt_pk_bf16_f32 v70, v84, v85
    v_cvt_pk_bf16_f32 v71, v86, v87
    buffer_store_dwordx4 v[68:71], v2, s[24:27], s45 offen nt
    v_lshlrev_b32 v80, 16, v72
    v_and_b32 v81, 0xffff0000, v72
    v_lshlrev_b32 v82, 16, v73
    v_and_b32 v83, 0xffff0000, v73
    v_lshlrev_b32 v84, 16, v74
    v_and_b32 v85, 0xffff0000, v74
    v_lshlrev_b32 v86, 16, v75
    v_and_b32 v87, 0xffff0000, v75
    v_pk_mul_f32 v[80:81], v[80:81], v[8:9]
    v_pk_mul_f32 v[82:83], v[82:83], v[10:11]
    v_pk_mul_f32 v[84:85], v[84:85], v[12:13]
    v_pk_mul_f32 v[86:87], v[86:87], v[14:15]
    v_cvt_pk_bf16_f32 v72, v80, v81
    v_cvt_pk_bf16_f32 v73, v82, v83
    v_cvt_pk_bf16_f32 v74, v84, v85
    v_cvt_pk_bf16_f32 v75, v86, v87
    buffer_store_dwordx4 v[72:75], v2, s[24:27], s46 offen nt
    v_lshlrev_b32 v80, 16, v36
    v_and_b32 v81, 0xffff0000, v36
    v_lshlrev_b32 v82, 16, v37
    v_and_b32 v83, 0xffff0000, v37
    v_lshlrev_b32 v84, 16, v38
    v_and_b32 v85, 0xffff0000, v38
    v_lshlrev_b32 v86, 16, v39
    v_and_b32 v87, 0xffff0000, v39
    v_pk_mul_f32 v[80:81], v[80:81], v[8:9]
    v_pk_mul_f32 v[82:83], v[82:83], v[10:11]
    v_pk_mul_f32 v[84:85], v[84:85], v[12:13]
    v_pk_mul_f32 v[86:87], v[86:87], v[14:15]
    v_cvt_pk_bf16_f32 v36, v80, v81
    v_cvt_pk_bf16_f32 v37, v82, v83
    v_cvt_pk_bf16_f32 v38, v84, v85
    v_cvt_pk_bf16_f32 v39, v86, v87
    buffer_store_dwordx4 v[36:39], v2, s[24:27], s37 offen sc1
    v_lshlrev_b32 v80, 16, v76
    v_and_b32 v81, 0xffff0000, v76
    v_lshlrev_b32 v82, 16, v77
    v_and_b32 v83, 0xffff0000, v77
    v_lshlrev_b32 v84, 16, v78
    v_and_b32 v85, 0xffff0000, v78
    v_lshlrev_b32 v86, 16, v79
    v_and_b32 v87, 0xffff0000, v79
    v_pk_mul_f32 v[80:81], v[80:81], v[8:9]
    v_pk_mul_f32 v[82:83], v[82:83], v[10:11]
    v_pk_mul_f32 v[84:85], v[84:85], v[12:13]
    v_pk_mul_f32 v[86:87], v[86:87], v[14:15]
    v_cvt_pk_bf16_f32 v76, v80, v81
    v_cvt_pk_bf16_f32 v77, v82, v83
    v_cvt_pk_bf16_f32 v78, v84, v85
    v_cvt_pk_bf16_f32 v79, v86, v87
    buffer_store_dwordx4 v[76:79], v2, s[24:27], s47 offen nt
L_end:
    s_endpgm
L_flagwait:
    buffer_load_dword v88, v4, s[8:11], 0 offen sc1
    s_sub_u32 s19, s19, 1
    s_cmp_lt_i32 s19, 0
    s_cbranch_scc1 L_flagok
    s_waitcnt vmcnt(0)
    v_cmp_gt_u32 vcc, 96, v88
    s_cbranch_vccnz L_flagwait
    s_branch L_flagok
L_ctrl2:
    s_cmp_ge_u32 s34, 192
    s_cbranch_scc1 L_noflag
    s_mov_b32 s33, 1
    s_waitcnt vmcnt(0)
    s_atomic_add s33, s[12:13], 0
L_noflag:
    buffer_load_dword v52, v1, s[8:11], 0 offen offset:0
    buffer_load_dword v54, v1, s[8:11], 0 offen offset:192
    buffer_load_dword v56, v1, s[8:11], 0 offen offset:384
    buffer_load_dword v58, v1, s[8:11], 0 offen offset:576
    buffer_load_dword v60, v1, s[8:11], 0 offen offset:768
    buffer_load_dword v62, v1, s[8:11], 0 offen offset:960
    s_add_u32 s46, s76, 0x50000
    s_bfe_u32 s46, s46, 0x10013
    s_bfe_u32 s47, s2, 0x10002
    s_xor_b32 s47, s47, s46
    s_xor_b32 s47, s47, s41
    s_lshl_b32 s47, s47, 2
    s_xor_b32 s18, s2, s47
    s_lshl_b32 s46, s46, 2
    s_xor_b32 s40, s40, s46
    s_lshr_b32 s16, s18, 3
    s_lshl_b32 s16, s16, 2
    s_and_b32 s17, s18, 3
    s_add_u32 s16, s16, s17
    s_lshl_b32 s16, s16, 1
    s_bfe_u32 s17, s18, 0x10002
    s_add_u32 s16, s16, s17
    s_lshl_b32 s16, s16, 13
    v_lshl_add_u32 v2, v0, 4, s16
    s_lshl_b32 s17, s18, 7
    s_add_u32 s17, s17, 393216
    v_add_u32 v4, s17, v14
    v_and_b32 v5, 1, v0
    v_lshrrev_b32 v6, 4, v0
    v_lshl_add_u32 v5, v5, 2, v6
    s_lshl_b32 s17, s18, 3
    v_add_u32 v5, s17, v5
    v_mad_u32_u24 v5, v5, 6, v3
    v_lshlrev_b32 v5, 1, v5
    v_cmp_gt_u32 vcc, 6, v3
    v_mov_b32 v6, 0x10000
    s_mul_i32 s17, s40, 2048
    v_cndmask_b32 v5, v6, v5, vcc
    buffer_load_ushort v10, v5, s[24:27], 0 offen
    s_add_u32 s17, s17, 393216
    v_lshrrev_b32 v7, 3, v0
    v_lshlrev_b32 v7, 7, v7
    v_and_b32 v8, 7, v0
    v_lshl_add_u32 v7, v8, 2, v7
    v_add_u32 v7, s17, v7
    v_mov_b32 v9, 0x7fffffc0
    v_cmp_gt_u32 vcc, 32, v0
    v_add_u32 v8, 1024, v7
    s_nop 0
    v_cndmask_b32 v8, v9, v8, vcc
    v_lshlrev_b32 v9, 3, v0
    v_add_u32 v9, 26880, v9
    s_waitcnt vmcnt(0) lgkmcnt(0)
    v_and_b32 v53, 0xffff0000, v52
    v_lshlrev_b32 v52, 16, v52
    v_and_b32 v55, 0xffff0000, v54
    v_lshlrev_b32 v54, 16, v54
    v_and_b32 v57, 0xffff0000, v56
    v_lshlrev_b32 v56, 16, v56
    v_and_b32 v59, 0xffff0000, v58
    v_lshlrev_b32 v58, 16, v58
    v_and_b32 v61, 0xffff0000, v60
    v_lshlrev_b32 v60, 16, v60
    v_and_b32 v63, 0xffff0000, v62
    v_lshlrev_b32 v62, 16, v62
    v_lshlrev_b32 v10, 16, v10
    s_cmp_ge_u32 s18, 12
    s_barrier
    s_cbranch_scc1 L_poll2
    buffer_load_dwordx4 v[20:23], v2, s[28:31], 0 offen offset:0 sc1
    buffer_load_dwordx4 v[24:27], v2, s[28:31], 0 offen offset:1024 sc1
    buffer_load_dwordx4 v[28:31], v2, s[28:31], 0 offen offset:2048 sc1
    buffer_load_dwordx4 v[32:35], v2, s[28:31], 0 offen offset:3072 sc1
    buffer_load_dwordx4 v[36:39], v2, s[28:31], s44 offen offset:0 sc1
    buffer_load_dwordx4 v[40:43], v2, s[28:31], s44 offen offset:1024 sc1
    buffer_load_dwordx4 v[44:47], v2, s[28:31], s44 offen offset:2048 sc1
    buffer_load_dwordx4 v[48:51], v2, s[28:31], s44 offen offset:3072 sc1
    s_mov_b64 s[42:43], -1
    s_branch L_gsum
L_gagain:
    s_mov_b64 exec, s[40:41]
    buffer_load_dwordx4 v[20:23], v2, s[28:31], 0 offen offset:0 sc1
    buffer_load_dwordx4 v[24:27], v2, s[28:31], 0 offen offset:1024 sc1
    buffer_load_dwordx4 v[28:31], v2, s[28:31], 0 offen offset:2048 sc1
    buffer_load_dwordx4 v[32:35], v2, s[28:31], 0 offen offset:3072 sc1
    buffer_load_dwordx4 v[36:39], v2, s[28:31], s44 offen offset:0 sc1
    buffer_load_dwordx4 v[40:43], v2, s[28:31], s44 offen offset:1024 sc1
    buffer_load_dwordx4 v[44:47], v2, s[28:31], s44 offen offset:2048 sc1
    buffer_load_dwordx4 v[48:51], v2, s[28:31], s44 offen offset:3072 sc1
    v_max3_u32 v12, v20, v21, v22
    v_max3_u32 v12, v12, v23, v24
    v_max3_u32 v12, v12, v25, v26
    v_max3_u32 v12, v12, v27, v28
    v_max3_u32 v12, v12, v29, v30
    v_max3_u32 v12, v12, v31, v32
    v_max3_u32 v12, v12, v33, v34
    v_max3_u32 v12, v12, v35, v36
    v_max3_u32 v12, v12, v37, v38
    v_max3_u32 v12, v12, v39, v40
    v_max3_u32 v12, v12, v41, v42
    v_max3_u32 v12, v12, v43, v44
    v_max3_u32 v12, v12, v45, v46
    v_max3_u32 v12, v12, v47, v48
    v_max3_u32 v12, v12, v49, v50
    v_max_u32 v12, v12, v51
    v_cmp_eq_u32 s[42:43], -1, v12
    s_sub_u32 s19, s19, 1
    s_cmp_lt_i32 s19, 0
    s_cbranch_scc1 L_gdone
    buffer_load_dwordx4 v[20:23], v2, s[28:31], 0 offen offset:0 sc1
    buffer_load_dwordx4 v[24:27], v2, s[28:31], 0 offen offset:1024 sc1
    buffer_load_dwordx4 v[28:31], v2, s[28:31], 0 offen offset:2048 sc1
    buffer_load_dwordx4 v[32:35], v2, s[28:31], 0 offen offset:3072 sc1
    buffer_load_dwordx4 v[36:39], v2, s[28:31], s44 offen offset:0 sc1
    buffer_load_dwordx4 v[40:43], v2, s[28:31], s44 offen offset:1024 sc1
    buffer_load_dwordx4 v[44:47], v2, s[28:31], s44 offen offset:2048 sc1
    buffer_load_dwordx4 v[48:51], v2, s[28:31], s44 offen offset:3072 sc1
L_gsum2:
    s_waitcnt vmcnt(14)
    v_pk_add_f32 v[16:17], v[20:21], v[24:25]
    v_pk_add_f32 v[18:19], v[22:23], v[26:27]
    s_waitcnt vmcnt(12)
    v_pk_add_f32 v[64:65], v[28:29], v[32:33]
    v_pk_add_f32 v[66:67], v[30:31], v[34:35]
    v_pk_add_f32 v[16:17], v[16:17], v[64:65]
    v_pk_add_f32 v[18:19], v[18:19], v[66:67]
    s_waitcnt vmcnt(10)
    v_pk_add_f32 v[68:69], v[36:37], v[40:41]
    v_pk_add_f32 v[70:71], v[38:39], v[42:43]
    s_waitcnt vmcnt(8)
    v_pk_add_f32 v[72:73], v[44:45], v[48:49]
    v_pk_add_f32 v[74:75], v[46:47], v[50:51]
    v_pk_add_f32 v[68:69], v[68:69], v[72:73]
    v_pk_add_f32 v[70:71], v[70:71], v[74:75]
    v_pk_add_f32 v[16:17], v[16:17], v[68:69]
    v_pk_add_f32 v[18:19], v[18:19], v[70:71]
    s_branch L_gchk
L_gsum:
    s_waitcnt vmcnt(6)
    v_pk_add_f32 v[16:17], v[20:21], v[24:25]
    v_pk_add_f32 v[18:19], v[22:23], v[26:27]
    s_waitcnt vmcnt(4)
    v_pk_add_f32 v[64:65], v[28:29], v[32:33]
    v_pk_add_f32 v[66:67], v[30:31], v[34:35]
    v_pk_add_f32 v[16:17], v[16:17], v[64:65]
    v_pk_add_f32 v[18:19], v[18:19], v[66:67]
    s_waitcnt vmcnt(2)
    v_pk_add_f32 v[68:69], v[36:37], v[40:41]
    v_pk_add_f32 v[70:71], v[38:39], v[42:43]
    s_waitcnt vmcnt(0)
    v_pk_add_f32 v[72:73], v[44:45], v[48:49]
    v_pk_add_f32 v[74:75], v[46:47], v[50:51]
    v_pk_add_f32 v[68:69], v[68:69], v[72:73]
    v_pk_add_f32 v[70:71], v[70:71], v[74:75]
    v_pk_add_f32 v[16:17], v[16:17], v[68:69]
    v_pk_add_f32 v[18:19], v[18:19], v[70:71]
L_gchk:
    v_cmp_u_f32 vcc, v16, v17
    v_cmp_u_f32 s[40:41], v18, v19
    s_or_b64 s[40:41], s[40:41], vcc
    s_cbranch_scc0 L_gdone
    s_cmp_lg_u64 s[42:43], 0
    s_cbranch_scc1 L_gagain
L_gdone:
    s_mov_b64 exec, -1
    v_permlane32_swap_b32 v16, v18
    v_permlane32_swap_b32 v17, v19
    v_add_f32 v16, v16, v18
    v_add_f32 v17, v17, v19
    s_nop 1
    v_permlane16_swap_b32 v16, v17
    v_add_f32 v16, v16, v17
    s_nop 1
    v_add_f32_dpp v16, v16, v16 row_ror:8 row_mask:0xf bank_mask:0xf
    s_nop 1
    v_add_f32_dpp v16, v16, v16 row_ror:4 row_mask:0xf bank_mask:0xf
    s_nop 1
    v_add_f32_dpp v16, v16, v16 row_ror:2 row_mask:0xf bank_mask:0xf
    v_mul_f32 v16, 0x36800000, v16
    v_cvt_pk_bf16_f32 v16, v16, v16
    v_lshlrev_b32 v16, 16, v16
    v_mul_f32 v16, v16, v10
    s_nop 1
    v_add_f32_dpp v16, v16, v16 quad_perm:[1,0,3,2] row_mask:0xf bank_mask:0xf
    v_mov_b32 v17, v16
    s_nop 1
    v_permlane16_swap_b32 v16, v17
    v_add_f32 v16, v16, v17
    v_mov_b32 v17, v16
    s_nop 1
    v_permlane32_swap_b32 v16, v17
    v_add_f32 v16, v16, v17
    buffer_store_dword v16, v4, s[28:31], 0 offen sc1
L_poll2:
    buffer_load_dword v16, v7, s[28:31], 0 offen sc1
    buffer_load_dword v17, v8, s[28:31], 0 offen sc1
    s_sub_u32 s19, s19, 1
    s_cmp_lt_i32 s19, 0
    s_cbranch_scc1 L_p2done
    s_waitcnt vmcnt(0)
    v_max_u32 v12, v16, v17
    v_cmp_eq_u32 vcc, -1, v12
    s_cbranch_vccnz L_poll2
L_p2done:
    s_waitcnt vmcnt(0)
    v_add_f32 v16, v16, v17
    s_nop 1
    v_add_f32_dpp v16, v16, v16 row_ror:8 row_mask:0xf bank_mask:0xf
    v_mov_b32 v17, v16
    s_nop 1
    v_permlane16_swap_b32 v16, v17
    v_add_f32 v16, v16, v17
    v_mov_b32 v17, v16
    s_nop 1
    v_permlane32_swap_b32 v16, v17
    v_add_f32 v16, v16, v17
    v_cvt_pk_bf16_f32 v16, v16, v16
    v_lshlrev_b32 v16, 16, v16
    v_mul_f32 v17, 0xbfb8aa3b, v16
    v_exp_f32 v17, v17
    s_nop 0
    v_add_f32 v17, 1.0, v17
    v_rcp_f32 v17, v17
    s_nop 0
    v_mul_f32 v16, v16, v17
    v_cvt_pk_bf16_f32 v16, v16, v16
    v_lshlrev_b32 v16, 16, v16
    s_nop 1
    v_mul_f32_dpp v18, v16, v52 row_newbcast:0 row_mask:0xf bank_mask:0xf
    v_mul_f32_dpp v19, v16, v53 row_newbcast:0 row_mask:0xf bank_mask:0xf
    v_fmac_f32_dpp v18, v16, v54 row_newbcast:1 row_mask:0xf bank_mask:0xf
    v_fmac_f32_dpp v19, v16, v55 row_newbcast:1 row_mask:0xf bank_mask:0xf
    v_fmac_f32_dpp v18, v16, v56 row_newbcast:2 row_mask:0xf bank_mask:0xf
    v_fmac_f32_dpp v19, v16, v57 row_newbcast:2 row_mask:0xf bank_mask:0xf
    v_fmac_f32_dpp v18, v16, v58 row_newbcast:3 row_mask:0xf bank_mask:0xf
    v_fmac_f32_dpp v19, v16, v59 row_newbcast:3 row_mask:0xf bank_mask:0xf
    v_fmac_f32_dpp v18, v16, v60 row_newbcast:4 row_mask:0xf bank_mask:0xf
    v_fmac_f32_dpp v19, v16, v61 row_newbcast:4 row_mask:0xf bank_mask:0xf
    v_fmac_f32_dpp v18, v16, v62 row_newbcast:5 row_mask:0xf bank_mask:0xf
    v_fmac_f32_dpp v19, v16, v63 row_newbcast:5 row_mask:0xf bank_mask:0xf
    v_cvt_pk_bf16_f32 v18, v18, v19
    v_and_b32 v19, 0xffff0000, v18
    v_lshlrev_b32 v18, 16, v18
    v_mul_f32 v19, 0xbfb8aa3b, v19
    v_mul_f32 v18, 0xbfb8aa3b, v18
    v_exp_f32 v19, v19
    v_exp_f32 v18, v18
    v_add_f32 v19, 1.0, v19
    v_add_f32 v18, 1.0, v18
    v_rcp_f32 v19, v19
    v_rcp_f32 v18, v18
    s_nop 0
    v_cvt_pk_bf16_f32 v18, v18, v19
    v_and_b32 v19, 0xffff0000, v18
    v_lshlrev_b32 v18, 16, v18
    ds_write_b64 v9, v[18:19]
    s_waitcnt lgkmcnt(0)
    s_barrier
L_last:
    s_endpgm
.section .rodata,"a"
.p2align 6
.amdhsa_kernel standalone__se_block__vision_kernel
.amdhsa_next_free_vgpr 96
.amdhsa_next_free_sgpr 96
.amdhsa_accum_offset 96
.amdhsa_group_segment_fixed_size 0
.amdhsa_kernarg_size 48
.amdhsa_user_sgpr_count 2
.amdhsa_user_sgpr_kernarg_segment_ptr 1
.amdhsa_system_sgpr_workgroup_id_x 1
.amdhsa_float_denorm_mode_32 3
.end_amdhsa_kernel
```
